```python
import torch

def _softmax(x, axis=-1):
    return torch.softmax(x, dim=axis)
def _gelu(x):
    return torch.nn.functional.gelu(x, approximate="tanh")
def _silu(x):
    return torch.nn.functional.silu(x)
def _sigmoid(x):
    return torch.sigmoid(x)
def _layernorm(x, axis=-1, eps=1e-5):
    m = x.mean(dim=axis, keepdim=True)
    v = x.var(dim=axis, keepdim=True, unbiased=False)
    return (x - m) / torch.sqrt(v + eps)
def _scatter_add(tgt, idx, src, axis=0):
    return tgt.clone().index_add_(axis, idx, src)
def _segment_sum(src, seg, n):
    out = torch.zeros((n,) + src.shape[1:], dtype=src.dtype)
    return out.index_add_(0, seg, src)
def _pad(x, pw):
    flat = tuple(v for pair in reversed(pw) for v in pair)
    return torch.nn.functional.pad(x, flat)

kernel_name = 'parallel_sum__sliding_block_cached__dense_activation_gelu__decode'

def setup_inputs():

    _w = (lambda a: (lambda t: t.to(torch.bfloat16) if t.is_floating_point() else t)(torch.as_tensor(a)))
    def _A_setup():
        B, Sq, D = 1, 1, 448
        Hq, Hkv, Sk, Dh = 16, 8, 8192, 256
        assert Hq % Hkv == 0, (Hq, Hkv)
        return {
            "x": _w((lambda *s: torch.randn(*s, dtype=torch.bfloat16) * 0.05)(B, Sq, D)),
            "k_cache": _w((lambda *s: torch.randn(*s, dtype=torch.bfloat16) * 1.6)(B, Hkv, Sk, Dh)),
            "v_cache": _w((lambda *s: torch.randn(*s, dtype=torch.bfloat16) * 0.4)(B, Hkv, Sk, Dh)),
            "wq": _w((lambda *s: torch.randn(*s, dtype=torch.bfloat16) * 1.6)(D, Hq * Dh) * (D ** -0.5)),
            "wo": _w((lambda *s: torch.randn(*s, dtype=torch.bfloat16) * 0.4)(Hq * Dh, D) * ((Hq * Dh) ** -0.5)),
        }
    _A_in = _A_setup()

    def _B_setup():
        B, S, D, F = 1, 1, 448, 1792
        return {
            "x": _w((lambda *s: torch.randn(*s, dtype=torch.bfloat16) * 0.05)(B, S, D)),
            "w1": _w((lambda *s: torch.randn(*s, dtype=torch.bfloat16) * 0.8)(D, F) * (D ** -0.5)),
            "b1": _w((lambda *s: torch.randn(*s, dtype=torch.bfloat16) * 12.8)(F) * 0.01),
            "w2": _w((lambda *s: torch.randn(*s, dtype=torch.bfloat16) * 0.2)(F, D) * (F ** -0.5)),
            "b2": _w((lambda *s: torch.randn(*s, dtype=torch.bfloat16) * 1.6)(D) * 0.01),
        }
    _B_in = _B_setup()

    return {
        "A_x": _A_in["x"],
        "A_k_cache": _A_in["k_cache"],
        "A_v_cache": _A_in["v_cache"],
        "A_wq": _A_in["wq"],
        "A_wo": _A_in["wo"],
        "B_x": _B_in["x"],
        "B_w1": _B_in["w1"],
        "B_b1": _B_in["b1"],
        "B_w2": _B_in["w2"],
        "B_b2": _B_in["b2"],
    }

def reference(A_x, A_k_cache, A_v_cache, A_wq, A_wo, B_x, B_w1, B_b1, B_w2, B_b2):
    def _A_ref(x, k_cache, v_cache, wq, wo):
        B, Sq, D = x.shape
        Hq, Dh = 16, 256
        Hkv, Sk = k_cache.shape[1], k_cache.shape[2]
        W = min(4096, max(256, Sk // 4))
        rep = Hq // Hkv
        q = (lambda x, *d: x.permute(*d))((x @ wq).reshape(B, Sq, Hq, Dh), 0, 2, 1, 3)
        k = (lambda x, n, axis: torch.repeat_interleave(x, n, dim=axis))(k_cache[:, :, Sk - W:, :], rep, axis=1)
        v = (lambda x, n, axis: torch.repeat_interleave(x, n, dim=axis))(v_cache[:, :, Sk - W:, :], rep, axis=1)
        scores = torch.einsum("bhqd,bhkd->bhqk", q, k) * (Dh ** -0.5)
        p = _softmax(scores, axis=-1)
        o = torch.einsum("bhqk,bhkd->bhqd", p, v)
        return (lambda x, *d: x.permute(*d))(o, 0, 2, 1, 3).reshape(B, Sq, Hq * Dh) @ wo

    def _B_ref(x, w1, b1, w2, b2):
        h = torch.einsum("bsd,df->bsf", x, w1) + b1
        h = _gelu(h)
        return torch.einsum("bsf,fd->bsd", h, w2) + b2

    x = A_x
    xn = _layernorm(x, axis=-1)
    return x + _A_ref(xn, A_k_cache, A_v_cache, A_wq, A_wo) + _B_ref(xn, B_w1, B_b1, B_w2, B_b2)
```

```asm
; @launch grid=(256,1,1) block=(320,1,1) lds=12288
.amdgcn_target "amdgcn-amd-amdhsa--gfx950"
.text
.globl parallel_sum__sliding_block_cached__dense_activation_gelu__decode_kernel
.p2align 8
.type parallel_sum__sliding_block_cached__dense_activation_gelu__decode_kernel,@function
parallel_sum__sliding_block_cached__dense_activation_gelu__decode_kernel:
    s_load_dwordx16 s[4:19], s[0:1], 0
    s_load_dwordx8 s[20:27], s[0:1], 64
    s_load_dwordx2 s[28:29], s[0:1], 96
    v_readfirstlane_b32 s34, v0
    s_cmpk_ge_u32 s2, 0x100
    s_cbranch_scc1 L_end
    s_and_b32 s30, s2, 7
    s_lshr_b32 s31, s2, 3
    s_lshr_b32 s34, s34, 6
    s_cbranch_scc0 L_G0
    s_branch L_A
L_G0:
    s_getpc_b64 s[56:57]
L_pc:
    v_lshlrev_b32 v1, 7, v0
    global_load_dword v1, v1, s[56:57] offset:200
    s_lshr_b32 s35, s2, 6
    s_mul_i32 s35, s35, 917504
    s_and_b32 s36, s31, 7
    s_lshl3_add_u32 s36, s30, s36
    s_lshl_b32 s36, s36, 7
    s_add_u32 s35, s35, s36
    v_lshrrev_b32 v2, 3, v0
    v_and_b32 v3, 7, v0
    v_mul_u32_u24 v116, 114688, v2
    v_lshl_add_u32 v116, v3, 4, v116
    v_add_u32 v116, s35, v116
    v_min_u32 v117, 55, v0
    v_lshlrev_b32 v117, 4, v117
    s_movk_i32 s40, 0x2000
    s_waitcnt lgkmcnt(0)
    global_load_dwordx4 v[4:7], v117, s[4:5]
    global_load_dwordx4 v[8:11], v116, s[10:11] nt
    v_add_u32 v116, s40, v116
    global_load_dwordx4 v[12:15], v116, s[10:11] nt
    v_add_u32 v116, s40, v116
    global_load_dwordx4 v[16:19], v116, s[10:11] nt
    v_add_u32 v116, s40, v116
    global_load_dwordx4 v[20:23], v116, s[10:11] nt
    v_add_u32 v116, s40, v116
    global_load_dwordx4 v[24:27], v116, s[10:11] nt
    v_add_u32 v116, s40, v116
    global_load_dwordx4 v[28:31], v116, s[10:11] nt
    v_add_u32 v116, s40, v116
    global_load_dwordx4 v[32:35], v116, s[10:11] nt
    v_add_u32 v116, s40, v116
    global_load_dwordx4 v[36:39], v116, s[10:11] nt
    v_add_u32 v116, s40, v116
    global_load_dwordx4 v[40:43], v116, s[10:11] nt
    v_add_u32 v116, s40, v116
    global_load_dwordx4 v[44:47], v116, s[10:11] nt
    v_add_u32 v116, s40, v116
    global_load_dwordx4 v[48:51], v116, s[10:11] nt
    v_add_u32 v116, s40, v116
    global_load_dwordx4 v[52:55], v116, s[10:11] nt
    v_add_u32 v116, s40, v116
    global_load_dwordx4 v[56:59], v116, s[10:11] nt
    v_add_u32 v116, s40, v116
    global_load_dwordx4 v[60:63], v116, s[10:11] nt
    s_load_dword s33, s[28:29], 0
    s_setprio 3
    s_lshl_b32 s35, s30, 13
    s_lshl_b32 s36, s31, 8
    s_add_u32 s35, s35, s36
    s_add_u32 s35, s35, 65536
    v_lshl_add_u32 v120, v3, 4, s35
    v_and_b32 v122, 16, v0
    v_lshl_add_u32 v120, v122, 3, v120
    global_load_dword v126, v120, s[28:29] nt
    global_load_dword v126, v120, s[28:29] sc1
    s_lshl2_add_u32 s62, s31, s30
    s_bitcmp1_b32 s31, 0
    s_cselect_b32 s62, 127, s62
    s_cmpk_lt_u32 s62, 112
    s_cselect_b32 s43, 1, 0
    s_cbranch_scc0 L_Gno1
    s_mul_i32 s41, s62, 2341
    s_lshr_b32 s41, s41, 16
    s_mul_i32 s35, s41, 28
    s_sub_u32 s62, s62, s35
    s_mul_i32 s36, s41, 224
    v_mad_u32_u24 v123, v2, 28, s36
    s_lshl_b32 s35, s62, 7
    v_lshl_add_u32 v118, v3, 4, s35
    s_movk_i32 s35, 1792
    v_mad_u32_u24 v118, v123, s35, v118
    s_movk_i32 s40, 7168
    global_load_dwordx4 v[136:139], v118, s[16:17] offset:0 nt
    global_load_dwordx4 v[140:143], v118, s[16:17] offset:3584 nt
    v_add_u32 v118, s40, v118
    global_load_dwordx4 v[144:147], v118, s[16:17] offset:0 nt
    global_load_dwordx4 v[148:151], v118, s[16:17] offset:3584 nt
    v_add_u32 v118, s40, v118
    global_load_dwordx4 v[152:155], v118, s[16:17] offset:0 nt
    global_load_dwordx4 v[156:159], v118, s[16:17] offset:3584 nt
    v_add_u32 v118, s40, v118
    global_load_dwordx4 v[160:163], v118, s[16:17] offset:0 nt
    global_load_dwordx4 v[164:167], v118, s[16:17] offset:3584 nt
    v_add_u32 v118, s40, v118
    global_load_dwordx4 v[168:171], v118, s[16:17] offset:0 nt
    global_load_dwordx4 v[172:175], v118, s[16:17] offset:3584 nt
    v_add_u32 v118, s40, v118
    global_load_dwordx4 v[176:179], v118, s[16:17] offset:0 nt
    global_load_dwordx4 v[180:183], v118, s[16:17] offset:3584 nt
    v_add_u32 v118, s40, v118
    global_load_dwordx4 v[184:187], v118, s[16:17] offset:0 nt
    global_load_dwordx4 v[188:191], v118, s[16:17] offset:3584 nt
    s_mul_i32 s36, s41, 7168
    s_lshl_b32 s35, s62, 8
    s_add_u32 s35, s35, s36
    s_add_u32 s35, s35, 4096
    v_lshl_add_u32 v121, v3, 5, s35
    v_add_u32 v121, v122, v121
L_Gj1:
    v_and_b32 v100, 1, v0
    v_lshlrev_b32 v100, 4, v100
    v_mov_b32 v101, 0xffff
    v_lshlrev_b32 v101, v100, v101
    v_bfe_u32 v100, v0, 1, 2
    v_cmp_eq_u32 vcc, 0, v100
    v_cmp_eq_u32 s[56:57], 1, v100
    v_cmp_eq_u32 s[60:61], 2, v100
    v_cndmask_b32 v96, 0, v101, vcc
    v_cmp_eq_u32 vcc, 3, v100
    v_cndmask_b32 v97, 0, v101, s[56:57]
    v_cndmask_b32 v98, 0, v101, s[60:61]
    v_cndmask_b32 v99, 0, v101, vcc
    s_mov_b32 s38, 0xffff0000
    v_cmp_gt_u32 s[54:55], 56, v0
    v_mov_b32 v132, 0x3b124925
    s_waitcnt vmcnt(30)
    s_barrier
    v_lshlrev_b32 v64, 16, v4
    v_and_b32 v65, s38, v4
    v_lshlrev_b32 v66, 16, v5
    v_and_b32 v67, s38, v5
    v_lshlrev_b32 v68, 16, v6
    v_and_b32 v69, s38, v6
    v_lshlrev_b32 v70, 16, v7
    v_and_b32 v71, s38, v7
    v_pk_add_f32 v[72:73], v[64:65], v[66:67]
    v_pk_add_f32 v[74:75], v[68:69], v[70:71]
    v_pk_add_f32 v[72:73], v[72:73], v[74:75]
    v_add_f32 v128, v72, v73
    v_cndmask_b32 v128, 0, v128, s[54:55]
    v_mov_b32 v100, 0x0c0c0c0c
    s_mov_b32 s48, 0x01000100
    v_add_f32_dpp v128, v128, v128 row_shr:1 row_mask:0xf bank_mask:0xf bound_ctrl:0
    s_mov_b32 s49, 0x03020302
    v_bfi_b32 v88, v96, s48, v100
    v_add_f32_dpp v128, v128, v128 row_shr:2 row_mask:0xf bank_mask:0xf bound_ctrl:0
    v_bfi_b32 v92, v96, s49, v100
    v_bfi_b32 v89, v97, s48, v100
    v_add_f32_dpp v128, v128, v128 row_shr:4 row_mask:0xf bank_mask:0xf bound_ctrl:0
    v_bfi_b32 v93, v97, s49, v100
    v_bfi_b32 v90, v98, s48, v100
    v_add_f32_dpp v128, v128, v128 row_shr:8 row_mask:0xf bank_mask:0xf bound_ctrl:0
    v_bfi_b32 v94, v98, s49, v100
    v_bfi_b32 v91, v99, s48, v100
    v_add_f32_dpp v128, v128, v128 row_bcast:15 row_mask:0xa bank_mask:0xf
    v_bfi_b32 v95, v99, s49, v100
    v_mov_b32 v119, 0xff
    v_add_f32_dpp v128, v128, v128 row_bcast:31 row_mask:0xc bank_mask:0xf
    v_lshlrev_b32 v124, 4, v0
    s_lshr_b32 s50, s2, 6
    v_readlane_b32 s35, v128, 63
    s_mul_i32 s50, s50, 224
    v_mad_u32_u24 v125, v2, 28, s50
    v_mul_f32 v130, s35, v132
    v_pk_add_f32 v[72:73], v[64:65], v[130:131] op_sel_hi:[1,0] neg_lo:[0,1] neg_hi:[0,1]
    v_pk_add_f32 v[74:75], v[66:67], v[130:131] op_sel_hi:[1,0] neg_lo:[0,1] neg_hi:[0,1]
    v_pk_add_f32 v[76:77], v[68:69], v[130:131] op_sel_hi:[1,0] neg_lo:[0,1] neg_hi:[0,1]
    v_pk_add_f32 v[78:79], v[70:71], v[130:131] op_sel_hi:[1,0] neg_lo:[0,1] neg_hi:[0,1]
    v_pk_mul_f32 v[128:129], v[72:73], v[72:73]
    v_pk_fma_f32 v[128:129], v[74:75], v[74:75], v[128:129]
    v_pk_fma_f32 v[128:129], v[76:77], v[76:77], v[128:129]
    v_pk_fma_f32 v[128:129], v[78:79], v[78:79], v[128:129]
    v_add_f32 v128, v128, v129
    v_cndmask_b32 v128, 0, v128, s[54:55]
    v_cvt_pk_bf16_f32 v130, v130, v130
    v_and_b32 v130, s38, v130
    v_add_f32_dpp v128, v128, v128 row_shr:1 row_mask:0xf bank_mask:0xf bound_ctrl:0
    v_pk_add_f32 v[72:73], v[64:65], v[130:131] op_sel_hi:[1,0] neg_lo:[0,1] neg_hi:[0,1]
    v_pk_add_f32 v[74:75], v[66:67], v[130:131] op_sel_hi:[1,0] neg_lo:[0,1] neg_hi:[0,1]
    v_add_f32_dpp v128, v128, v128 row_shr:2 row_mask:0xf bank_mask:0xf bound_ctrl:0
    v_pk_add_f32 v[76:77], v[68:69], v[130:131] op_sel_hi:[1,0] neg_lo:[0,1] neg_hi:[0,1]
    v_pk_add_f32 v[78:79], v[70:71], v[130:131] op_sel_hi:[1,0] neg_lo:[0,1] neg_hi:[0,1]
    v_add_f32_dpp v128, v128, v128 row_shr:4 row_mask:0xf bank_mask:0xf bound_ctrl:0
    v_cvt_pk_bf16_f32 v64, v72, v73
    v_cvt_pk_bf16_f32 v65, v74, v75
    v_add_f32_dpp v128, v128, v128 row_shr:8 row_mask:0xf bank_mask:0xf bound_ctrl:0
    v_cvt_pk_bf16_f32 v66, v76, v77
    v_cvt_pk_bf16_f32 v67, v78, v79
    v_add_f32_dpp v128, v128, v128 row_bcast:15 row_mask:0xa bank_mask:0xf
    v_lshlrev_b32 v72, 16, v64
    v_and_b32 v73, s38, v64
    v_add_f32_dpp v128, v128, v128 row_bcast:31 row_mask:0xc bank_mask:0xf
    v_lshlrev_b32 v74, 16, v65
    v_and_b32 v75, s38, v65
    v_readlane_b32 s35, v128, 63
    v_lshlrev_b32 v76, 16, v66
    v_and_b32 v77, s38, v66
    v_mul_f32 v132, s35, v132
    v_cvt_pk_bf16_f32 v132, v132, v132
    v_and_b32 v132, s38, v132
    v_add_f32 v132, 0x3727c5ac, v132
    v_cvt_pk_bf16_f32 v132, v132, v132
    v_and_b32 v132, s38, v132
    v_sqrt_f32 v132, v132
    v_lshlrev_b32 v78, 16, v67
    v_cvt_pk_bf16_f32 v132, v132, v132
    v_and_b32 v132, s38, v132
    v_rcp_f32 v132, v132
    v_and_b32 v79, s38, v67
    v_pk_mul_f32 v[72:73], v[72:73], v[132:133] op_sel_hi:[1,0]
    v_pk_mul_f32 v[74:75], v[74:75], v[132:133] op_sel_hi:[1,0]
    v_pk_mul_f32 v[76:77], v[76:77], v[132:133] op_sel_hi:[1,0]
    v_pk_mul_f32 v[78:79], v[78:79], v[132:133] op_sel_hi:[1,0]
    v_cvt_pk_bf16_f32 v64, v72, v73
    v_cvt_pk_bf16_f32 v65, v74, v75
    v_cvt_pk_bf16_f32 v66, v76, v77
    v_cvt_pk_bf16_f32 v67, v78, v79
    ds_write_b128 v124, v[64:67] offset:0
    ds_read2_b32 v[100:101], v125 offset0:0 offset1:1
    ds_read2_b32 v[102:103], v125 offset0:2 offset1:3
    ds_read2_b32 v[104:105], v125 offset0:4 offset1:5
    ds_read_b32 v106, v125 offset:24
    s_waitcnt lgkmcnt(0)
    v_perm_b32 v64, v100, v100, v88
    v_perm_b32 v65, v100, v100, v89
    v_perm_b32 v66, v100, v100, v90
    v_perm_b32 v67, v100, v100, v91
    v_perm_b32 v68, v100, v100, v92
    v_perm_b32 v69, v100, v100, v93
    v_perm_b32 v70, v100, v100, v94
    v_perm_b32 v71, v100, v100, v95
    s_add_u32 s33, s33, 0x5b3d27c5
    s_bfe_u32 s44, s33, 0x80000
    s_bfe_u32 s45, s33, 0x80008
    s_bfe_u32 s46, s33, 0x80010
    s_bfe_u32 s47, s33, 0x80018
    s_getreg_b32 s35, hwreg(HW_REG_XCC_ID, 0, 4)
    s_and_b32 s42, s33, 0xf0
    s_or_b32 s42, s42, s35
    v_perm_b32 v72, v101, v101, v88
    v_perm_b32 v73, v101, v101, v89
    v_perm_b32 v74, v101, v101, v90
    v_perm_b32 v75, v101, v101, v91
    v_perm_b32 v76, v101, v101, v92
    v_perm_b32 v77, v101, v101, v93
    v_perm_b32 v78, v101, v101, v94
    v_perm_b32 v79, v101, v101, v95
    s_waitcnt vmcnt(29)
    v_mfma_f32_16x16x32_bf16 v[108:111], v[64:67], v[8:11], 0
    s_waitcnt vmcnt(28)
    v_mfma_f32_16x16x32_bf16 v[108:111], v[68:71], v[12:15], v[108:111]
    v_perm_b32 v80, v102, v102, v88
    v_perm_b32 v81, v102, v102, v89
    v_perm_b32 v82, v102, v102, v90
    v_perm_b32 v83, v102, v102, v91
    v_perm_b32 v84, v102, v102, v92
    v_perm_b32 v85, v102, v102, v93
    v_perm_b32 v86, v102, v102, v94
    v_perm_b32 v87, v102, v102, v95
    s_waitcnt vmcnt(27)
    v_mfma_f32_16x16x32_bf16 v[108:111], v[72:75], v[16:19], v[108:111]
    s_waitcnt vmcnt(26)
    v_mfma_f32_16x16x32_bf16 v[108:111], v[76:79], v[20:23], v[108:111]
    v_perm_b32 v64, v103, v103, v88
    v_perm_b32 v65, v103, v103, v89
    v_perm_b32 v66, v103, v103, v90
    v_perm_b32 v67, v103, v103, v91
    v_perm_b32 v68, v103, v103, v92
    v_perm_b32 v69, v103, v103, v93
    v_perm_b32 v70, v103, v103, v94
    v_perm_b32 v71, v103, v103, v95
    s_waitcnt vmcnt(25)
    v_mfma_f32_16x16x32_bf16 v[108:111], v[80:83], v[24:27], v[108:111]
    s_waitcnt vmcnt(24)
    v_mfma_f32_16x16x32_bf16 v[108:111], v[84:87], v[28:31], v[108:111]
    v_perm_b32 v72, v104, v104, v88
    v_perm_b32 v73, v104, v104, v89
    v_perm_b32 v74, v104, v104, v90
    v_perm_b32 v75, v104, v104, v91
    v_perm_b32 v76, v104, v104, v92
    v_perm_b32 v77, v104, v104, v93
    v_perm_b32 v78, v104, v104, v94
    v_perm_b32 v79, v104, v104, v95
    s_waitcnt vmcnt(23)
    v_mfma_f32_16x16x32_bf16 v[108:111], v[64:67], v[32:35], v[108:111]
    s_waitcnt vmcnt(22)
    v_mfma_f32_16x16x32_bf16 v[108:111], v[68:71], v[36:39], v[108:111]
    v_perm_b32 v80, v105, v105, v88
    v_perm_b32 v81, v105, v105, v89
    v_perm_b32 v82, v105, v105, v90
    v_perm_b32 v83, v105, v105, v91
    v_perm_b32 v84, v105, v105, v92
    v_perm_b32 v85, v105, v105, v93
    v_perm_b32 v86, v105, v105, v94
    v_perm_b32 v87, v105, v105, v95
    s_waitcnt vmcnt(21)
    v_mfma_f32_16x16x32_bf16 v[108:111], v[72:75], v[40:43], v[108:111]
    s_waitcnt vmcnt(20)
    v_mfma_f32_16x16x32_bf16 v[108:111], v[76:79], v[44:47], v[108:111]
    v_perm_b32 v64, v106, v106, v88
    v_perm_b32 v65, v106, v106, v89
    v_perm_b32 v66, v106, v106, v90
    v_perm_b32 v67, v106, v106, v91
    v_perm_b32 v68, v106, v106, v92
    v_perm_b32 v69, v106, v106, v93
    v_perm_b32 v70, v106, v106, v94
    v_perm_b32 v71, v106, v106, v95
    s_waitcnt vmcnt(19)
    v_mfma_f32_16x16x32_bf16 v[108:111], v[80:83], v[48:51], v[108:111]
    s_waitcnt vmcnt(18)
    v_mfma_f32_16x16x32_bf16 v[108:111], v[84:87], v[52:55], v[108:111]
    s_waitcnt vmcnt(17)
    v_mfma_f32_16x16x32_bf16 v[108:111], v[64:67], v[56:59], v[108:111]
    s_waitcnt vmcnt(16)
    v_mfma_f32_16x16x32_bf16 v[108:111], v[68:71], v[60:63], v[108:111]
    s_nop 7
    v_permlane32_swap_b32 v108, v112
    v_permlane32_swap_b32 v109, v113
    v_permlane32_swap_b32 v110, v114
    v_permlane32_swap_b32 v111, v115
    v_add_f32_dpp v108, v112, v108 row_ror:8 row_mask:0xf bank_mask:0xf
    v_add_f32_dpp v109, v113, v109 row_ror:8 row_mask:0xf bank_mask:0xf
    v_add_f32_dpp v110, v114, v110 row_ror:8 row_mask:0xf bank_mask:0xf
    v_add_f32_dpp v111, v115, v111 row_ror:8 row_mask:0xf bank_mask:0xf
    s_mov_b64 exec, 0x00ff00ff
    v_bfi_b32 v108, v119, s42, v108
    v_bfi_b32 v109, v119, s45, v109
    v_bfi_b32 v110, v119, s46, v110
    v_bfi_b32 v111, v119, s47, v111
    global_store_dwordx4 v120, v[108:111], s[28:29]
    ds_write_b128 v124, v[108:111] offset:2560
    s_mov_b64 exec, -1
    s_waitcnt lgkmcnt(0)
    s_barrier
    s_setprio 0
    s_cmp_eq_u32 s43, 1
    s_cbranch_scc0 L_Gtail
    ds_read2_b32 v[100:101], v123 offset0:0 offset1:1
    ds_read2_b32 v[102:103], v123 offset0:2 offset1:3
    ds_read2_b32 v[104:105], v123 offset0:4 offset1:5
    ds_read_b32 v106, v123 offset:24
    s_waitcnt lgkmcnt(0)
    v_perm_b32 v64, v100, v100, v88
    v_perm_b32 v65, v100, v100, v89
    v_perm_b32 v66, v100, v100, v90
    v_perm_b32 v67, v100, v100, v91
    v_perm_b32 v68, v100, v100, v92
    v_perm_b32 v69, v100, v100, v93
    v_perm_b32 v70, v100, v100, v94
    v_perm_b32 v71, v100, v100, v95
    v_perm_b32 v72, v101, v101, v88
    v_perm_b32 v73, v101, v101, v89
    v_perm_b32 v74, v101, v101, v90
    v_perm_b32 v75, v101, v101, v91
    v_perm_b32 v76, v101, v101, v92
    v_perm_b32 v77, v101, v101, v93
    v_perm_b32 v78, v101, v101, v94
    v_perm_b32 v79, v101, v101, v95
    s_waitcnt vmcnt(14)
    v_mfma_f32_16x16x32_bf16 v[8:11], v[64:67], v[136:139], 0
    s_waitcnt vmcnt(13)
    v_mfma_f32_16x16x32_bf16 v[8:11], v[68:71], v[140:143], v[8:11]
    v_perm_b32 v80, v102, v102, v88
    v_perm_b32 v81, v102, v102, v89
    v_perm_b32 v82, v102, v102, v90
    v_perm_b32 v83, v102, v102, v91
    v_perm_b32 v84, v102, v102, v92
    v_perm_b32 v85, v102, v102, v93
    v_perm_b32 v86, v102, v102, v94
    v_perm_b32 v87, v102, v102, v95
    s_waitcnt vmcnt(12)
    v_mfma_f32_16x16x32_bf16 v[8:11], v[72:75], v[144:147], v[8:11]
    s_waitcnt vmcnt(11)
    v_mfma_f32_16x16x32_bf16 v[8:11], v[76:79], v[148:151], v[8:11]
    v_perm_b32 v64, v103, v103, v88
    v_perm_b32 v65, v103, v103, v89
    v_perm_b32 v66, v103, v103, v90
    v_perm_b32 v67, v103, v103, v91
    v_perm_b32 v68, v103, v103, v92
    v_perm_b32 v69, v103, v103, v93
    v_perm_b32 v70, v103, v103, v94
    v_perm_b32 v71, v103, v103, v95
    s_waitcnt vmcnt(10)
    v_mfma_f32_16x16x32_bf16 v[8:11], v[80:83], v[152:155], v[8:11]
    s_waitcnt vmcnt(9)
    v_mfma_f32_16x16x32_bf16 v[8:11], v[84:87], v[156:159], v[8:11]
    v_perm_b32 v72, v104, v104, v88
    v_perm_b32 v73, v104, v104, v89
    v_perm_b32 v74, v104, v104, v90
    v_perm_b32 v75, v104, v104, v91
    v_perm_b32 v76, v104, v104, v92
    v_perm_b32 v77, v104, v104, v93
    v_perm_b32 v78, v104, v104, v94
    v_perm_b32 v79, v104, v104, v95
    s_waitcnt vmcnt(8)
    v_mfma_f32_16x16x32_bf16 v[8:11], v[64:67], v[160:163], v[8:11]
    s_waitcnt vmcnt(7)
    v_mfma_f32_16x16x32_bf16 v[8:11], v[68:71], v[164:167], v[8:11]
    v_perm_b32 v80, v105, v105, v88
    v_perm_b32 v81, v105, v105, v89
    v_perm_b32 v82, v105, v105, v90
    v_perm_b32 v83, v105, v105, v91
    v_perm_b32 v84, v105, v105, v92
    v_perm_b32 v85, v105, v105, v93
    v_perm_b32 v86, v105, v105, v94
    v_perm_b32 v87, v105, v105, v95
    s_waitcnt vmcnt(6)
    v_mfma_f32_16x16x32_bf16 v[8:11], v[72:75], v[168:171], v[8:11]
    s_waitcnt vmcnt(5)
    v_mfma_f32_16x16x32_bf16 v[8:11], v[76:79], v[172:175], v[8:11]
    v_perm_b32 v64, v106, v106, v88
    v_perm_b32 v65, v106, v106, v89
    v_perm_b32 v66, v106, v106, v90
    v_perm_b32 v67, v106, v106, v91
    v_perm_b32 v68, v106, v106, v92
    v_perm_b32 v69, v106, v106, v93
    v_perm_b32 v70, v106, v106, v94
    v_perm_b32 v71, v106, v106, v95
    s_waitcnt vmcnt(4)
    v_mfma_f32_16x16x32_bf16 v[8:11], v[80:83], v[176:179], v[8:11]
    s_waitcnt vmcnt(3)
    v_mfma_f32_16x16x32_bf16 v[8:11], v[84:87], v[180:183], v[8:11]
    s_waitcnt vmcnt(2)
    v_mfma_f32_16x16x32_bf16 v[8:11], v[64:67], v[184:187], v[8:11]
    s_waitcnt vmcnt(1)
    v_mfma_f32_16x16x32_bf16 v[8:11], v[68:71], v[188:191], v[8:11]
    s_nop 7
    v_permlane32_swap_b32 v8, v12
    v_permlane32_swap_b32 v9, v13
    v_permlane32_swap_b32 v10, v14
    v_permlane32_swap_b32 v11, v15
    v_add_f32_dpp v8, v12, v8 row_ror:8 row_mask:0xf bank_mask:0xf
    v_add_f32_dpp v9, v13, v9 row_ror:8 row_mask:0xf bank_mask:0xf
    v_add_f32_dpp v10, v14, v10 row_ror:8 row_mask:0xf bank_mask:0xf
    v_add_f32_dpp v11, v15, v11 row_ror:8 row_mask:0xf bank_mask:0xf
    s_mov_b64 exec, 0x00ff00ff
    v_bfi_b32 v8, v119, s44, v8
    v_bfi_b32 v9, v119, s45, v9
    v_bfi_b32 v10, v119, s46, v10
    v_bfi_b32 v11, v119, s47, v11
    s_mov_b64 exec, -1
    s_branch L_Gtail
L_Gno1:
    v_mov_b32 v123, 0
    v_mov_b32 v121, v120
    global_load_dword v136, v123, s[4:5]
    global_load_dword v136, v123, s[4:5]
    global_load_dword v136, v123, s[4:5]
    global_load_dword v136, v123, s[4:5]
    global_load_dword v136, v123, s[4:5]
    global_load_dword v136, v123, s[4:5]
    global_load_dword v136, v123, s[4:5]
    global_load_dword v136, v123, s[4:5]
    global_load_dword v136, v123, s[4:5]
    global_load_dword v136, v123, s[4:5]
    global_load_dword v136, v123, s[4:5]
    global_load_dword v136, v123, s[4:5]
    global_load_dword v136, v123, s[4:5]
    global_load_dword v136, v123, s[4:5]
    s_branch L_Gj1
L_A:
    s_mov_b64 exec, -1
    s_sub_u32 s34, s34, 1
    v_subrev_u32 v0, 64, v0
    s_lshl_b32 s32, s30, 22
    s_lshl_b32 s35, s31, 15
    s_add_u32 s32, s32, s35
    s_lshl_b32 s35, s34, 11
    s_add_u32 s32, s32, s35
    s_add_u32 s32, s32, 0x300000
    s_and_b32 s36, s31, 3
    s_lshl_b32 s36, s36, 7
    s_add_u32 s35, s32, s36
    v_and_b32 v29, 48, v0
    v_bfe_u32 v30, v0, 2, 2
    v_lshl_add_u32 v10, v30, 9, v29
    v_and_b32 v30, 2, v0
    v_lshl_add_u32 v10, v30, 12, v10
    v_and_b32 v31, 1, v0
    v_lshl_add_u32 v10, v31, 6, v10
    v_add_u32 v10, s35, v10
    v_xor_b32 v11, 0x80, v10
    v_xor_b32 v12, 0x100, v10
    v_xor_b32 v13, 0x180, v10
    s_waitcnt lgkmcnt(0)
    s_load_dword s33, s[28:29], 0
    s_add_u32 s58, s6, 0x4000
    s_addc_u32 s59, s7, 0
    v_and_b32 v3, 7, v0
    s_barrier
    global_load_dwordx4 v[52:55], v10, s[6:7] nt
    s_lshl_b32 s35, s34, 8
    v_lshl_add_u32 v22, v3, 4, s35
    global_load_dwordx4 v[56:59], v11, s[6:7] nt
    v_and_b32 v30, 8, v0
    v_add_u32 v22, v22, v30
    global_load_dwordx4 v[60:63], v12, s[6:7] nt
    v_and_b32 v31, 16, v0
    v_lshl_add_u32 v22, v31, 3, v22
    v_bfe_u32 v31, v0, 5, 1
    v_lshl_add_u32 v22, v31, 2, v22
    s_and_b32 s35, s34, 2
    s_lshl_b32 s35, s35, 6
    v_xor_b32 v22, s35, v22
    s_bitcmp1_b32 s31, 0
    s_cbranch_scc0 L_k1
    global_load_dwordx4 v[64:67], v13, s[6:7] nt
    s_mov_b32 s43, 0
    s_mov_b32 s43, 0
    global_load_dwordx4 v[68:71], v10, s[58:59] nt
    s_mov_b32 s43, 0
    s_mov_b32 s43, 0
    global_load_dwordx4 v[72:75], v11, s[58:59] nt
    s_mov_b32 s43, 0
    s_mov_b32 s43, 0
L_k1:
    v_and_b32 v30, 15, v0
    s_and_b32 s35, s31, 1
    s_lshl_b32 s35, s35, 8
    s_add_u32 s35, s35, s32
    v_lshlrev_b32 v14, 5, v29
    v_lshl_add_u32 v14, v30, 4, v14
    v_add_u32 v14, s35, v14
    v_xor_b32 v15, 0x100, v14
    s_add_u32 s48, s8, 0x2000
    s_addc_u32 s49, s9, 0
    s_add_u32 s50, s8, 0x4000
    s_addc_u32 s51, s9, 0
    s_add_u32 s52, s8, 0x6000
    s_addc_u32 s53, s9, 0
    v_bfe_u32 v2, v0, 3, 3
    v_and_b32 v3, 7, v0
    s_lshl_b32 s62, s30, 16
    s_add_u32 s62, s62, 1048576
    s_lshl_b32 s36, s31, 6
    s_add_u32 s35, s62, s36
    s_lshl_b32 s36, s34, 14
    s_add_u32 s35, s35, s36
    v_and_b32 v30, 3, v0
    v_lshl_add_u32 v17, v30, 4, s35
    v_and_b32 v30, 28, v0
    v_lshl_add_u32 v17, v30, 9, v17
    s_lshl_b32 s35, s30, 13
    s_lshl_b32 s36, s34, 9
    s_add_u32 s35, s35, s36
    s_add_u32 s35, s35, 65536
    v_and_b32 v30, 31, v0
    v_lshl_add_u32 v16, v30, 4, s35
    v_and_b32 v30, 32, v0
    v_lshl_add_u32 v16, v30, 7, v16
    s_lshr_b32 s41, s31, 1
    v_mov_b32 v9, 0
    s_and_b32 s35, s31, 3
    s_cbranch_scc1 L_setN
    s_add_u32 s36, s31, s34
    s_lshl_b32 s35, s36, 11
    s_add_u32 s35, s35, s62
    v_and_b32 v31, 63, v0
    v_lshl_add_u32 v18, v31, 4, s35
    v_and_b32 v31, 28, v0
    s_lshl_b32 s35, s30, 12
    s_and_b32 s62, s36, 8
    s_lshl_b32 s62, s62, 8
    s_add_u32 s35, s35, s62
    s_and_b32 s62, s36, 16
    s_lshl_b32 s62, s62, 6
    s_add_u32 s35, s35, s62
    s_and_b32 s62, s36, 7
    s_lshl_b32 s62, s62, 7
    s_add_u32 s35, s35, s62
    s_and_b32 s62, s35, 0x6000
    s_add_u32 s35, s35, s62
    s_add_u32 s35, s35, 524288
    v_and_b32 v30, 3, v0
    v_lshl_add_u32 v19, v30, 4, s35
    v_lshl_add_u32 v19, v31, 14, v19
    v_and_b32 v31, 16, v0
    v_lshlrev_b32 v31, 9, v31
    v_xor_b32 v19, v31, v19
    v_mov_b32 v20, 0
    v_mov_b32 v21, 0
    global_load_dword v1, v19, s[28:29] sc1
    s_branch L_setJ
L_setN:
    s_min_u32 s62, s30, 6
    s_lshl_b32 s62, s62, 7
    s_bitcmp1_b32 s31, 0
    s_cbranch_scc0 L_setF
    s_lshl_b32 s35, s41, 8
    s_and_b32 s36, s34, 2
    s_lshl_b32 s36, s36, 6
    s_add_u32 s35, s35, s36
    s_and_b32 s36, s34, 1
    s_lshl2_add_u32 s35, s36, s35
    s_mul_i32 s35, s35, 896
    s_add_u32 s35, s35, s62
    v_mul_u32_u24 v18, 7168, v2
    v_lshl_add_u32 v18, v3, 4, v18
    v_add_u32 v18, s35, v18
    v_add_u32 v19, 57344, v18
    s_lshl2_add_u32 s36, s41, s34
    s_lshl_b32 s35, s36, 9
    s_and_b32 s62, s35, 0x6000
    s_add_u32 s35, s35, s62
    s_and_b32 s62, s30, 4
    s_lshl_b32 s62, s62, 11
    s_add_u32 s35, s35, s62
    s_lshl_b32 s62, s30, 16
    s_add_u32 s35, s35, s62
    s_add_u32 s35, s35, 524288
    v_lshl_add_u32 v20, v2, 4, s35
    v_lshl_add_u32 v20, v30, 1, v20
    s_branch L_setR
L_setF:
    s_and_b32 s36, s31, -4
    s_add_u32 s36, s36, s34
    s_mul_i32 s35, s36, 56
    s_add_u32 s36, s36, 64
    v_min_u32 v30, 6, v2
    v_lshl_add_u32 v30, v30, 3, s35
    v_mul_u32_u24 v18, 896, v30
    v_lshl_add_u32 v18, v3, 4, v18
    v_add_u32 v18, s62, v18
    v_add_u32 v19, 3584, v18
    v_add_lshl_u32 v9, v30, v3, 1
    v_and_b32 v31, 4, v0
    v_add_lshl_u32 v20, v30, v31, 2
    v_and_b32 v31, 3, v0
    v_mul_u32_u24 v31, 7168, v31
    v_add_u32 v20, v31, v20
    v_add_u32 v20, 4096, v20
L_setR:
    s_lshl_b32 s62, s30, 15
    s_lshl4_add_u32 s35, s36, s62
    s_add_u32 s35, s35, 262144
    v_lshl_add_u32 v21, v3, 12, s35
    v_and_b32 v30, 16, v0
    v_lshl_add_u32 v21, v30, 7, v21
L_setJ:
    v_and_b32 v30, 1, v0
    v_lshlrev_b32 v30, 4, v30
    v_mov_b32 v31, 0xffff
    v_lshlrev_b32 v31, v30, v31
    v_bfe_u32 v30, v0, 1, 2
    v_cmp_eq_u32 vcc, 0, v30
    v_cmp_eq_u32 s[56:57], 1, v30
    v_cmp_eq_u32 s[60:61], 2, v30
    v_cndmask_b32 v4, 0, v31, vcc
    v_cmp_eq_u32 vcc, 3, v30
    v_cndmask_b32 v5, 0, v31, s[56:57]
    v_cndmask_b32 v6, 0, v31, s[60:61]
    v_cndmask_b32 v7, 0, v31, vcc
    v_mov_b32 v8, 0xff
    s_mov_b32 s38, 0xffff0000
    s_mov_b32 s39, 0x3db8aa3b
    v_mov_b32 v30, 0x0c0c0c0c
    s_mov_b32 s36, 0x03020302
    v_bfi_b32 v36, v4, s36, v30
    v_bfi_b32 v37, v5, s36, v30
    v_bfi_b32 v38, v6, s36, v30
    v_bfi_b32 v39, v7, s36, v30
    v_mov_b32 v28, 0
    s_barrier
    s_bitcmp1_b32 s31, 0
    s_cbranch_scc1 L_k2
    global_load_dwordx4 v[64:67], v13, s[6:7] nt
    s_mov_b32 s43, 0
    s_mov_b32 s43, 0
    global_load_dwordx4 v[68:71], v10, s[58:59] nt
    s_mov_b32 s43, 0
    s_mov_b32 s43, 0
    global_load_dwordx4 v[72:75], v11, s[58:59] nt
    s_mov_b32 s43, 0
    s_mov_b32 s43, 0
L_k2:
    global_load_dwordx4 v[76:79], v12, s[58:59] nt
    v_and_b32 v30, 8, v0
    v_mul_u32_u24 v32, 80, v30
    global_load_dwordx4 v[80:83], v13, s[58:59] nt
    v_and_b32 v31, 1, v0
    v_lshl_add_u32 v32, v31, 6, v32
    global_load_dwordx4 v[84:87], v14, s[8:9] nt
    v_add_u32 v32, v32, v29
    s_and_b32 s35, s31, 3
    global_load_dwordx4 v[88:91], v15, s[8:9] nt
    s_lshl_b32 s35, s35, 7
    v_xor_b32 v32, s35, v32
    global_load_dwordx4 v[92:95], v14, s[48:49] nt
    v_xor_b32 v33, 0x80, v32
    v_xor_b32 v34, 0x100, v32
    global_load_dwordx4 v[96:99], v15, s[48:49] nt
    v_xor_b32 v35, 0x180, v32
    s_lshl_b32 s35, s34, 2
    s_barrier
    global_load_dwordx4 v[116:119], v16, s[28:29] sc1
    global_load_dwordx4 v[120:123], v16, s[28:29] offset:2048 sc1
    v_lshl_add_u32 v23, v30, 2, s35
    s_lshl_b32 s35, s34, 1
    global_load_dwordx4 v[100:103], v14, s[50:51] nt
    s_and_b32 s36, s31, 1
    s_add_u32 s35, s35, s36
    global_load_dwordx4 v[104:107], v15, s[50:51] nt
    s_lshl_b32 s35, s35, 10
    v_and_b32 v31, 63, v0
    global_load_dwordx4 v[108:111], v14, s[52:53] nt
    v_lshl_add_u32 v26, v31, 4, s35
    v_xor_b32 v27, 0x400, v26
    global_load_dwordx4 v[112:115], v15, s[52:53] nt
    v_and_b32 v31, 31, v0
    s_lshl_b32 s35, s34, 9
    global_load_dwordx4 v[124:127], v16, s[28:29] sc1
    global_load_dwordx4 v[128:131], v16, s[28:29] offset:2048 sc1
    s_barrier
    v_lshl_add_u32 v24, v31, 4, s35
    v_bfe_u32 v31, v0, 5, 1
    v_lshl_add_u32 v24, v31, 3, v24
    s_and_b32 s35, s34, 1
    s_lshl_b32 s35, s35, 5
    v_mov_b32 v25, s35
    s_mov_b32 s37, 200000
    v_mov_b32 v40, 0
    ds_write_b32 v23, v28 offset:2048
    s_waitcnt lgkmcnt(0)
    s_add_u32 s33, s33, 0x5b3d27c5
    s_bfe_u32 s44, s33, 0x80000
    s_bfe_u32 s45, s33, 0x80008
    s_bfe_u32 s46, s33, 0x80010
    s_bfe_u32 s47, s33, 0x80018
    s_getreg_b32 s35, hwreg(HW_REG_XCC_ID, 0, 4)
    s_and_b32 s42, s33, 0xf0
    s_or_b32 s42, s42, s35
    s_waitcnt vmcnt(6)
L_qchk:
    v_xor_b32 v116, s42, v116
    v_xor_b32 v117, s45, v117
    v_xor_b32 v120, s42, v120
    v_xor_b32 v121, s45, v121
    v_xor_b32 v118, s46, v118
    v_xor_b32 v119, s47, v119
    v_xor_b32 v122, s46, v122
    v_xor_b32 v123, s47, v123
L_qsum:
    v_pk_add_f32 v[132:133], v[116:117], v[120:121]
    v_pk_add_f32 v[134:135], v[118:119], v[122:123]
    v_or3_b32 v30, v117, v118, v119
    v_or3_b32 v31, v116, v120, v123
    v_permlane32_swap_b32 v132, v134
    v_permlane32_swap_b32 v133, v135
    v_pk_add_f32 v[132:133], v[132:133], v[134:135]
    v_cvt_pk_bf16_f32 v132, v132, v133
    ds_write_b32 v22, v132 offset:1024
    v_or3_b32 v30, v30, v121, v122
    v_bitop3_b32 v31, v30, v31, v8 bitop3:0xa8
    v_cmp_ne_u32 vcc, 0, v31
    s_cbranch_vccnz L_qslow
L_qok:
    s_waitcnt lgkmcnt(0)
    s_barrier
    ds_read_b128 v[140:143], v32 offset:1024
    ds_read_b128 v[144:147], v33 offset:1024
    ds_read_b128 v[148:151], v34 offset:1024
    ds_read_b128 v[152:155], v35 offset:1024
    ds_read_b128 v[40:43], v28 offset:2048
    s_waitcnt lgkmcnt(4)
    v_mfma_f32_16x16x32_bf16 v[132:135], v[52:55], v[140:143], 0
    v_mfma_f32_16x16x32_bf16 v[136:139], v[68:71], v[140:143], 0
    s_waitcnt lgkmcnt(3)
    v_mfma_f32_16x16x32_bf16 v[132:135], v[56:59], v[144:147], v[132:135]
    v_mfma_f32_16x16x32_bf16 v[136:139], v[72:75], v[144:147], v[136:139]
    s_waitcnt lgkmcnt(2)
    v_mfma_f32_16x16x32_bf16 v[132:135], v[60:63], v[148:151], v[132:135]
    v_mfma_f32_16x16x32_bf16 v[136:139], v[76:79], v[148:151], v[136:139]
    s_waitcnt lgkmcnt(1)
    v_mfma_f32_16x16x32_bf16 v[132:135], v[64:67], v[152:155], v[132:135]
    v_mfma_f32_16x16x32_bf16 v[136:139], v[80:83], v[152:155], v[136:139]
    s_waitcnt lgkmcnt(0)
    v_or3_b32 v40, v40, v41, v42
    v_or_b32 v40, v40, v43
    v_add_u32 v17, v17, v40
    v_add_u32 v21, v21, v40
    v_readfirstlane_b32 s43, v40
    s_nop 0
    v_mov_b32_dpp v140, v133 quad_perm:[1,1,3,3] row_mask:0xf bank_mask:0xf
    v_mov_b32_dpp v141, v135 quad_perm:[1,1,3,3] row_mask:0xf bank_mask:0xf
    v_mov_b32_dpp v142, v137 quad_perm:[1,1,3,3] row_mask:0xf bank_mask:0xf
    v_mov_b32_dpp v143, v139 quad_perm:[1,1,3,3] row_mask:0xf bank_mask:0xf
    v_add_f32_dpp v140, v132, v140 quad_perm:[0,0,2,2] row_mask:0xf bank_mask:0xf
    v_add_f32_dpp v141, v134, v141 quad_perm:[0,0,2,2] row_mask:0xf bank_mask:0xf
    v_add_f32_dpp v142, v136, v142 quad_perm:[0,0,2,2] row_mask:0xf bank_mask:0xf
    v_add_f32_dpp v143, v138, v143 quad_perm:[0,0,2,2] row_mask:0xf bank_mask:0xf
    v_max3_f32 v120, v140, v141, v142
    v_max_f32 v121, v120, v143
    v_max_f32 v120, v120, v143
    v_cvt_pk_bf16_f32 v117, v140, v141
    v_cvt_pk_bf16_f32 v119, v142, v143
    v_permlane32_swap_b32 v120, v121
    v_max_f32 v30, v120, v121
    v_max_f32 v121, v120, v121
    v_lshlrev_b32 v116, 16, v117
    v_lshlrev_b32 v118, 16, v119
    v_permlane16_swap_b32 v30, v121
    v_max_f32 v120, v30, v121
    v_cvt_pk_bf16_f32 v120, v120, v120
    v_and_b32 v117, s38, v117
    v_and_b32 v120, s38, v120
    v_mul_f32 v120, s39, v120
    v_and_b32 v119, s38, v119
    v_fma_f32 v116, v116, s39, -v120
    v_fma_f32 v117, v117, s39, -v120
    v_exp_f32 v116, v116
    v_fma_f32 v118, v118, s39, -v120
    v_exp_f32 v117, v117
    v_fma_f32 v119, v119, s39, -v120
    v_exp_f32 v118, v118
    v_exp_f32 v119, v119
    ds_write_b32 v23, v120 offset:2112
    v_add_f32 v121, v116, v117
    v_add_f32 v30, v118, v119
    v_add_f32 v122, v121, v30
    v_add_f32 v121, v121, v30
    v_cvt_pk_bf16_f32 v123, v116, v116
    v_and_b32 v156, v123, v4
    v_and_b32 v157, v123, v5
    v_and_b32 v158, v123, v6
    v_and_b32 v159, v123, v7
    v_permlane32_swap_b32 v121, v122
    v_add_f32 v30, v121, v122
    v_add_f32 v122, v121, v122
    v_mfma_f32_16x16x32_bf16 v[132:135], v[156:159], v[84:87], 0
    v_mfma_f32_16x16x32_bf16 v[136:139], v[156:159], v[88:91], 0
    v_permlane16_swap_b32 v30, v122
    v_add_f32 v121, v30, v122
    ds_write_b32 v23, v121 offset:2128
    v_cvt_pk_bf16_f32 v123, v117, v117
    v_and_b32 v160, v123, v4
    v_and_b32 v161, v123, v5
    v_and_b32 v162, v123, v6
    v_and_b32 v163, v123, v7
    v_cvt_pk_bf16_f32 v123, v118, v118
    v_and_b32 v164, v123, v4
    v_and_b32 v165, v123, v5
    v_and_b32 v166, v123, v6
    v_and_b32 v167, v123, v7
    v_mfma_f32_16x16x32_bf16 v[132:135], v[160:163], v[92:95], v[132:135]
    v_mfma_f32_16x16x32_bf16 v[136:139], v[160:163], v[96:99], v[136:139]
    v_cvt_pk_bf16_f32 v123, v119, v119
    v_and_b32 v168, v123, v4
    v_and_b32 v169, v123, v5
    v_and_b32 v170, v123, v6
    v_and_b32 v171, v123, v7
    s_waitcnt lgkmcnt(0)
    s_barrier
    ds_read_b128 v[140:143], v25 offset:2112
    ds_read_b128 v[144:147], v25 offset:2128
    s_waitcnt vmcnt(5)
    v_mfma_f32_16x16x32_bf16 v[132:135], v[164:167], v[100:103], v[132:135]
    s_waitcnt vmcnt(4)
    v_mfma_f32_16x16x32_bf16 v[136:139], v[164:167], v[104:107], v[136:139]
    s_waitcnt vmcnt(3)
    v_mfma_f32_16x16x32_bf16 v[132:135], v[168:171], v[108:111], v[132:135]
    s_waitcnt vmcnt(2)
    v_mfma_f32_16x16x32_bf16 v[136:139], v[168:171], v[112:115], v[136:139]
    s_waitcnt lgkmcnt(0)
    v_max3_f32 v120, v140, v141, v142
    v_max_f32 v120, v120, v143
    v_pk_add_f32 v[140:141], v[140:141], v[120:121] op_sel_hi:[1,0] neg_lo:[0,1] neg_hi:[0,1]
    v_pk_add_f32 v[142:143], v[142:143], v[120:121] op_sel_hi:[1,0] neg_lo:[0,1] neg_hi:[0,1]
    v_exp_f32 v140, v140
    ds_write_b128 v26, v[132:135] offset:4096
    v_exp_f32 v141, v141
    ds_write_b128 v27, v[136:139] offset:4096
    v_exp_f32 v142, v142
    v_exp_f32 v143, v143
    v_mul_f32 v121, v140, v144
    v_fmac_f32 v121, v141, v145
    v_fmac_f32 v121, v142, v146
    v_fmac_f32 v121, v143, v147
    v_rcp_f32 v122, v121
    v_log_f32 v121, v121
    s_waitcnt lgkmcnt(0)
    s_barrier
    ds_read_b64 v[156:157], v24 offset:4096
    ds_read_b64 v[158:159], v24 offset:6144
    ds_read_b64 v[160:161], v24 offset:8192
    ds_read_b64 v[162:163], v24 offset:10240
    v_pk_mul_f32 v[140:141], v[140:141], v[122:123] op_sel_hi:[1,0]
    v_pk_mul_f32 v[142:143], v[142:143], v[122:123] op_sel_hi:[1,0]
    v_add_f32 v118, v120, v121
    v_mov_b32 v119, s33
    v_mov_b32 v31, s33
    s_mov_b32 s35, 0x05040100
    s_mov_b32 s37, 200000
    s_cmp_eq_u32 s43, 0
    s_waitcnt lgkmcnt(3)
    v_pk_mul_f32 v[132:133], v[156:157], v[140:141] op_sel_hi:[1,0]
    s_waitcnt lgkmcnt(2)
    v_pk_fma_f32 v[132:133], v[158:159], v[140:141], v[132:133] op_sel:[0,1,0] op_sel_hi:[1,1,1]
    s_waitcnt lgkmcnt(1)
    v_pk_fma_f32 v[132:133], v[160:161], v[142:143], v[132:133] op_sel_hi:[1,0,1]
    s_waitcnt lgkmcnt(0)
    v_pk_fma_f32 v[132:133], v[162:163], v[142:143], v[132:133] op_sel:[0,1,0] op_sel_hi:[1,1,1]
    s_nop 0
    v_cvt_pk_bf16_f32 v116, v132, v133
    s_nop 1
    v_permlane32_swap_b32 v116, v117
    s_mov_b64 exec, 0xffffffff
    s_cbranch_scc0 L_oslow
    global_store_dwordx4 v17, v[116:119], s[28:29]
L_opub:
    s_mov_b64 exec, -1
    s_and_b32 s62, s31, 3
    s_barrier
    s_cbranch_scc1 L_N
    v_add_u32 v18, s43, v18
    v_and_b32 v30, 16, v0
    v_lshrrev_b32 v40, v30, v31
L_ochk:
    global_load_dwordx4 v[52:55], v18, s[28:29] offset:0 sc1
    global_load_dwordx4 v[56:59], v18, s[28:29] offset:1024 sc1
    s_sub_u32 s37, s37, 1
    s_waitcnt vmcnt(0)
    s_cbranch_scc1 L_ook
    v_bitop3_b32 v30, v55, v59, v31 bitop3:0x7e
    v_max_f32 v156, v54, v58
    v_cmp_ne_u32 vcc, 0, v30
    s_cbranch_vccnz L_ochk
L_ook:
    v_max_f32_dpp v156, v156, v156 row_ror:4 row_mask:0xf bank_mask:0xf
    v_lshlrev_b32 v164, 16, v52
    v_and_b32 v165, s38, v52
    v_max_f32_dpp v157, v156, v156 row_ror:8 row_mask:0xf bank_mask:0xf
    v_max_f32_dpp v156, v156, v156 row_ror:8 row_mask:0xf bank_mask:0xf
    v_lshlrev_b32 v166, 16, v53
    v_and_b32 v167, s38, v53
    v_permlane16_swap_b32 v156, v157
    v_max_f32 v158, v156, v157
    v_max_f32 v157, v156, v157
    v_lshlrev_b32 v168, 16, v56
    v_and_b32 v169, s38, v56
    v_permlane32_swap_b32 v158, v157
    v_max_f32 v156, v158, v157
    v_sub_f32 v54, v54, v156
    v_sub_f32 v58, v58, v156
    v_exp_f32 v54, v54
    v_exp_f32 v58, v58
    v_lshlrev_b32 v170, 16, v57
    v_and_b32 v171, s38, v57
    v_add_f32 v158, v54, v58
    v_pk_mul_f32 v[160:161], v[164:165], v[54:55] op_sel_hi:[1,0]
    v_pk_mul_f32 v[162:163], v[166:167], v[54:55] op_sel_hi:[1,0]
    v_add_f32_dpp v158, v158, v158 row_ror:4 row_mask:0xf bank_mask:0xf
    v_pk_fma_f32 v[160:161], v[168:169], v[58:59], v[160:161] op_sel_hi:[1,0,1]
    v_pk_fma_f32 v[162:163], v[170:171], v[58:59], v[162:163] op_sel_hi:[1,0,1]
    v_add_f32_dpp v159, v158, v158 row_ror:8 row_mask:0xf bank_mask:0xf
    v_add_f32_dpp v158, v158, v158 row_ror:8 row_mask:0xf bank_mask:0xf
    v_permlane32_swap_b32 v160, v162
    v_permlane32_swap_b32 v161, v163
    v_permlane16_swap_b32 v158, v159
    v_pk_add_f32 v[160:161], v[160:161], v[162:163]
    v_add_f32 v156, v158, v159
    v_add_f32 v159, v158, v159
    v_permlane16_swap_b32 v160, v161
    v_add_f32 v160, v160, v161
    v_permlane32_swap_b32 v156, v159
    v_add_f32 v158, v156, v159
    v_add_f32_dpp v160, v160, v160 row_ror:4 row_mask:0xf bank_mask:0xf
    v_rcp_f32 v158, v158
    s_nop 0
    v_add_f32_dpp v160, v160, v160 row_ror:8 row_mask:0xf bank_mask:0xf
    v_mul_f32 v160, v160, v158
    v_cvt_pk_bf16_f32 v160, v160, v160
    v_perm_b32 v132, v160, v40, s35
    v_perm_b32 v133, v160, v40, s35
    v_perm_b32 v134, v160, v40, s35
    v_perm_b32 v135, v160, v40, s35
    v_permlane16_swap_b32 v132, v133
    s_nop 0
    v_permlane16_swap_b32 v134, v135
    s_nop 1
    v_permlane32_swap_b32 v132, v134
    v_permlane32_swap_b32 v133, v135
    s_mov_b64 exec, 0x0fffffff
    global_store_dwordx4 v19, v[132:135], s[28:29] sc1
    s_cmp_eq_u32 s30, 7
    s_cbranch_scc1 L_fin
    s_barrier
    s_endpgm
L_Gtail:
    s_lshr_b32 s41, s31, 1
    s_min_u32 s62, s30, 6
    s_lshl_b32 s62, s62, 7
    s_lshl3_add_u32 s35, s41, s62
    v_lshrrev_b32 v127, 4, v0
    v_lshl_add_u32 v127, v127, 1, s35
    s_lshl_b32 s35, s30, 15
    s_lshl_b32 s36, s41, 11
    s_add_u32 s35, s35, s36
    s_add_u32 s32, s35, 262144
    v_mad_u32_u24 v118, v0, 24, s32
    s_bitcmp1_b32 s31, 0
    s_cbranch_scc0 L_GE
    s_lshl_b32 s35, s30, 16
    s_lshl_b32 s36, s41, 12
    s_add_u32 s35, s35, s36
    s_add_u32 s35, s35, 1048576
    v_lshl_add_u32 v116, v0, 6, s35
    s_barrier
    s_barrier
    global_load_dword v4, v116, s[28:29] nt
    global_load_dword v4, v116, s[28:29] sc1
L_Gx:
    s_barrier
    s_barrier
    s_barrier
    s_barrier
    s_endpgm
L_GE:
    v_lshl_add_u32 v116, v0, 4, s32
    v_and_b32 v117, 31, v0
    v_lshl_add_u32 v117, v117, 4, s32
    v_mov_b32 v120, 0
    s_mov_b32 s37, 200000
    s_barrier
    s_barrier
    s_cmp_eq_u32 s43, 1
    s_cbranch_scc0 L_hs
    s_mov_b64 exec, 0x00ff00ff
    global_store_dwordx4 v121, v[8:11], s[28:29] sc1
    s_mov_b64 exec, -1
L_hs:
    s_cmp_eq_u32 s30, 7
    s_cbranch_scc1 L_Gx
    global_load_dword v126, v118, s[28:29] nt
    global_load_dword v126, v118, s[28:29] sc1
    global_load_ushort v134, v127, s[22:23]
    global_load_ushort v135, v127, s[4:5]
    s_barrier
    ds_read_b128 v[108:111], v120 offset:2048
    s_barrier
    s_waitcnt lgkmcnt(0)
    v_or3_b32 v108, v108, v109, v110
    v_or_b32 v108, v108, v111
    v_add_u32 v116, v108, v116
    v_add_u32 v117, v108, v117
    s_barrier
    s_barrier
    s_waitcnt vmcnt(0)
    v_lshlrev_b32 v134, 16, v134
    v_lshlrev_b32 v135, 16, v135
    v_add_f32 v134, v134, v135
    s_barrier
    global_load_dwordx4 v[68:71], v117, s[28:29] offset:1024 sc1
    global_load_dwordx4 v[64:67], v116, s[28:29] sc1
    global_load_dwordx4 v[76:79], v117, s[28:29] offset:1024 sc1
    global_load_dwordx4 v[72:75], v116, s[28:29] sc1
L_rchk:
    global_load_dwordx4 v[84:87], v117, s[28:29] offset:1024 sc1
    global_load_dwordx4 v[80:83], v116, s[28:29] sc1
    s_waitcnt vmcnt(5)
    v_xor_b32 v112, s44, v68
    v_xor_b32 v113, s45, v69
    v_xor_b32 v114, s46, v70
    v_xor_b32 v115, s47, v71
    v_or3_b32 v128, v112, v113, v114
    s_waitcnt vmcnt(4)
    v_xor_b32 v108, s44, v64
    v_xor_b32 v109, s45, v65
    v_xor_b32 v110, s46, v66
    v_xor_b32 v111, s47, v67
    v_or3_b32 v128, v128, v115, v108
    v_or3_b32 v128, v128, v109, v110
    v_bitop3_b32 v128, v128, v111, v119 bitop3:0xa8
    v_cmp_ne_u32 vcc, 0, v128
    s_cbranch_vccz L_rok
    global_load_dwordx4 v[68:71], v117, s[28:29] offset:1024 sc1
    global_load_dwordx4 v[64:67], v116, s[28:29] sc1
    s_waitcnt vmcnt(5)
    v_xor_b32 v112, s44, v76
    v_xor_b32 v113, s45, v77
    v_xor_b32 v114, s46, v78
    v_xor_b32 v115, s47, v79
    v_or3_b32 v128, v112, v113, v114
    s_waitcnt vmcnt(4)
    v_xor_b32 v108, s44, v72
    v_xor_b32 v109, s45, v73
    v_xor_b32 v110, s46, v74
    v_xor_b32 v111, s47, v75
    v_or3_b32 v128, v128, v115, v108
    v_or3_b32 v128, v128, v109, v110
    v_bitop3_b32 v128, v128, v111, v119 bitop3:0xa8
    v_cmp_ne_u32 vcc, 0, v128
    s_cbranch_vccz L_rok
    global_load_dwordx4 v[76:79], v117, s[28:29] offset:1024 sc1
    global_load_dwordx4 v[72:75], v116, s[28:29] sc1
    s_waitcnt vmcnt(5)
    v_xor_b32 v112, s44, v84
    v_xor_b32 v113, s45, v85
    v_xor_b32 v114, s46, v86
    v_xor_b32 v115, s47, v87
    v_or3_b32 v128, v112, v113, v114
    s_waitcnt vmcnt(4)
    v_xor_b32 v108, s44, v80
    v_xor_b32 v109, s45, v81
    v_xor_b32 v110, s46, v82
    v_xor_b32 v111, s47, v83
    v_or3_b32 v128, v128, v115, v108
    v_or3_b32 v128, v128, v109, v110
    v_bitop3_b32 v128, v128, v111, v119 bitop3:0xa8
    v_cmp_ne_u32 vcc, 0, v128
    s_cbranch_vccz L_rok
    s_sub_u32 s37, s37, 1
    s_cbranch_scc0 L_rchk
L_rok:
    v_pk_fma_f32 v[108:109], v[112:113], 0.5, v[108:109] op_sel_hi:[1,0,1]
    v_pk_fma_f32 v[110:111], v[114:115], 0.5, v[110:111] op_sel_hi:[1,0,1]
    s_nop 1
    v_permlane32_swap_b32 v108, v110
    v_permlane32_swap_b32 v109, v111
    v_pk_add_f32 v[108:109], v[108:109], v[110:111]
    s_nop 1
    v_permlane16_swap_b32 v108, v109
    v_add_f32 v108, v108, v109
    s_nop 1
    v_add_f32_dpp v108, v108, v108 row_ror:1 row_mask:0xf bank_mask:0xf
    s_nop 1
    v_add_f32_dpp v108, v108, v108 row_ror:2 row_mask:0xf bank_mask:0xf
    s_nop 1
    v_add_f32_dpp v108, v108, v108 row_ror:4 row_mask:0xf bank_mask:0xf
    s_nop 1
    v_add_f32_dpp v108, v108, v108 row_ror:8 row_mask:0xf bank_mask:0xf
    s_mov_b32 exec_lo, 0x00010001
    s_mov_b32 exec_hi, 0x00010001
    v_add_f32 v108, v108, v134
    v_cvt_pk_bf16_f32 v108, v108, v108
    global_store_short v127, v108, s[24:25]
    s_cmp_eq_u32 s2, 0
    s_cbranch_scc0 L_fin
    s_mov_b64 exec, 1
    v_mov_b32 v128, s33
    global_store_dword v120, v128, s[28:29]
    s_endpgm
L_N:
    s_cmp_eq_u32 s30, 7
    s_cbranch_scc1 L_fin
    s_cmp_eq_u32 s62, 2
    s_cbranch_scc1 L_F
    global_load_dwordx4 v[84:87], v18, s[12:13] offset:0 nt
    v_mov_b32 v44, 0
    s_cmp_eq_u32 s43, 0
    global_load_dwordx4 v[88:91], v18, s[12:13] offset:896 nt
    v_mov_b32 v45, 0
    s_cmp_eq_u32 s43, 0
    global_load_dwordx4 v[92:95], v18, s[12:13] offset:1792 nt
    v_mov_b32 v46, 0
    s_cmp_eq_u32 s43, 0
    global_load_dwordx4 v[96:99], v18, s[12:13] offset:2688 nt
    v_mov_b32 v47, 0
    s_cmp_eq_u32 s43, 0
    global_load_dwordx4 v[100:103], v19, s[12:13] offset:0 nt
    v_mov_b32 v48, 0
    s_cmp_eq_u32 s43, 0
    global_load_dwordx4 v[104:107], v19, s[12:13] offset:896 nt
    v_mov_b32 v49, 0
    s_cmp_eq_u32 s43, 0
    global_load_dwordx4 v[108:111], v19, s[12:13] offset:1792 nt
    v_mov_b32 v50, 0
    s_cmp_eq_u32 s43, 0
    global_load_dwordx4 v[112:115], v19, s[12:13] offset:2688 nt
    s_cselect_b32 s62, 1, 0
    s_waitcnt vmcnt(3)
L_pchk:
    global_load_dwordx4 v[52:55], v20, s[28:29] offset:0 sc1
    global_load_dwordx4 v[56:59], v20, s[28:29] offset:256 sc1
L_pchk0:
    s_sub_u32 s37, s37, 1
    s_waitcnt vmcnt(0)
    s_cbranch_scc1 L_pok
    v_perm_b32 v120, v53, v52, s35
    v_perm_b32 v121, v55, v54, s35
    v_perm_b32 v122, v57, v56, s35
    v_perm_b32 v123, v59, v58, s35
    v_bitop3_b32 v120, v120, v121, v31 bitop3:0x7e
    v_bitop3_b32 v122, v122, v123, v31 bitop3:0x7e
    v_or_b32 v120, v120, v122
    v_cmp_ne_u32 vcc, 0, v120
    s_cbranch_vccnz L_pchk
L_pok:
    v_perm_b32 v156, v52, v52, v36
    v_perm_b32 v157, v52, v52, v37
    v_perm_b32 v158, v52, v52, v38
    v_perm_b32 v159, v52, v52, v39
    v_perm_b32 v160, v53, v53, v36
    v_perm_b32 v161, v53, v53, v37
    v_perm_b32 v162, v53, v53, v38
    v_perm_b32 v163, v53, v53, v39
    v_mfma_f32_16x16x32_bf16 v[44:47], v[156:159], v[84:87], 0
    v_perm_b32 v164, v54, v54, v36
    v_perm_b32 v165, v54, v54, v37
    v_perm_b32 v166, v54, v54, v38
    v_perm_b32 v167, v54, v54, v39
    v_mfma_f32_16x16x32_bf16 v[44:47], v[160:163], v[88:91], v[44:47]
    v_perm_b32 v168, v55, v55, v36
    v_perm_b32 v169, v55, v55, v37
    v_perm_b32 v170, v55, v55, v38
    v_perm_b32 v171, v55, v55, v39
    v_mfma_f32_16x16x32_bf16 v[44:47], v[164:167], v[92:95], v[44:47]
    v_perm_b32 v156, v56, v56, v36
    v_perm_b32 v157, v56, v56, v37
    v_perm_b32 v158, v56, v56, v38
    v_perm_b32 v159, v56, v56, v39
    v_mfma_f32_16x16x32_bf16 v[44:47], v[168:171], v[96:99], v[44:47]
    v_perm_b32 v160, v57, v57, v36
    v_perm_b32 v161, v57, v57, v37
    v_perm_b32 v162, v57, v57, v38
    v_perm_b32 v163, v57, v57, v39
    v_mfma_f32_16x16x32_bf16 v[44:47], v[156:159], v[100:103], v[44:47]
    v_perm_b32 v164, v58, v58, v36
    v_perm_b32 v165, v58, v58, v37
    v_perm_b32 v166, v58, v58, v38
    v_perm_b32 v167, v58, v58, v39
    v_mfma_f32_16x16x32_bf16 v[44:47], v[160:163], v[104:107], v[44:47]
    v_perm_b32 v168, v59, v59, v36
    v_perm_b32 v169, v59, v59, v37
    v_perm_b32 v170, v59, v59, v38
    v_perm_b32 v171, v59, v59, v39
    v_mfma_f32_16x16x32_bf16 v[44:47], v[164:167], v[108:111], v[44:47]
L_last1:
    s_cmp_eq_u32 s62, 1
    v_mfma_f32_16x16x32_bf16 v[44:47], v[168:171], v[112:115], v[44:47]
    s_nop 7
    v_permlane32_swap_b32 v44, v48
    v_permlane32_swap_b32 v45, v49
    v_permlane32_swap_b32 v46, v50
    v_permlane32_swap_b32 v47, v51
    v_add_f32_dpp v44, v48, v44 row_ror:8 row_mask:0xf bank_mask:0xf
    v_add_f32_dpp v45, v49, v45 row_ror:8 row_mask:0xf bank_mask:0xf
    v_add_f32_dpp v46, v50, v46 row_ror:8 row_mask:0xf bank_mask:0xf
    v_add_f32_dpp v47, v51, v47 row_ror:8 row_mask:0xf bank_mask:0xf
    s_mov_b64 exec, 0x00ff00ff
    v_bfi_b32 v44, v8, s44, v44
    v_bfi_b32 v45, v8, s45, v45
    v_bfi_b32 v46, v8, s46, v46
    v_bfi_b32 v47, v8, s47, v47
    s_cbranch_scc0 L_rslow
    global_store_dwordx4 v21, v[44:47], s[28:29]
L_rpub:
    s_bitcmp1_b32 s31, 0
    s_cbranch_scc1 L_fin
    s_barrier
    s_endpgm
L_F:
    global_load_dwordx4 v[84:87], v18, s[20:21] offset:0 nt
    v_and_b32 v30, 1, v0
    v_cmp_eq_u32 s[56:57], 1, v30
    global_load_dwordx4 v[88:91], v18, s[20:21] offset:896 nt
    v_and_b32 v30, 2, v0
    v_cmp_eq_u32 s[60:61], 2, v30
    global_load_dwordx4 v[92:95], v18, s[20:21] offset:1792 nt
    v_cmp_gt_u32 s[54:55], 7, v2
    s_cmp_eq_u32 s43, 0
    global_load_ushort v9, v9, s[18:19]
    global_load_dwordx4 v[52:55], v20, s[28:29] sc1
    global_load_dwordx4 v[96:99], v18, s[20:21] offset:2688 nt
    s_cselect_b32 s62, 1, 0
    v_mov_b32 v44, 0
    global_load_dwordx4 v[100:103], v19, s[20:21] offset:0 nt
    v_mov_b32 v45, 0
    v_mov_b32 v46, 0
    global_load_dwordx4 v[104:107], v19, s[20:21] offset:896 nt
    v_mov_b32 v47, 0
    v_mov_b32 v48, 0
    global_load_dwordx4 v[108:111], v19, s[20:21] offset:1792 nt
    v_mov_b32 v49, 0
    v_mov_b32 v50, 0
    global_load_dwordx4 v[112:115], v19, s[20:21] offset:2688 nt
    s_waitcnt vmcnt(5)
L_hchk:
    v_xor_b32 v52, s44, v52
    v_xor_b32 v53, s45, v53
    v_xor_b32 v54, s46, v54
    v_xor_b32 v55, s47, v55
    v_or3_b32 v30, v52, v53, v54
    v_bitop3_b32 v30, v30, v55, v8 bitop3:0xa8
    v_cmp_ne_u32 vcc, 0, v30
    s_cbranch_vccnz L_hretry
L_hok:
    v_add_f32_dpp v52, v52, v52 quad_perm:[1,0,3,2] row_mask:0xf bank_mask:0xf
    v_add_f32_dpp v53, v53, v53 quad_perm:[1,0,3,2] row_mask:0xf bank_mask:0xf
    v_add_f32_dpp v54, v54, v54 quad_perm:[1,0,3,2] row_mask:0xf bank_mask:0xf
    v_add_f32_dpp v55, v55, v55 quad_perm:[1,0,3,2] row_mask:0xf bank_mask:0xf
    v_add_f32_dpp v52, v52, v52 quad_perm:[2,3,0,1] row_mask:0xf bank_mask:0xf
    v_add_f32_dpp v53, v53, v53 quad_perm:[2,3,0,1] row_mask:0xf bank_mask:0xf
    v_add_f32_dpp v54, v54, v54 quad_perm:[2,3,0,1] row_mask:0xf bank_mask:0xf
    v_add_f32_dpp v55, v55, v55 quad_perm:[2,3,0,1] row_mask:0xf bank_mask:0xf
    v_cndmask_b32 v52, v52, v53, s[56:57]
    v_cndmask_b32 v54, v54, v55, s[56:57]
    v_lshlrev_b32 v9, 16, v9
    v_cndmask_b32 v52, v52, v54, s[60:61]
    v_cvt_pk_bf16_f32 v52, v52, v52
    v_and_b32 v52, s38, v52
    v_add_f32 v52, v52, v9
    v_cvt_pk_bf16_f32 v52, v52, v52
    v_and_b32 v52, s38, v52
    v_mul_f32 v53, v52, v52
    v_mov_b32 v54, 0xc0135761
    v_fmac_f32 v54, 0xbdd2d3e8, v53
    v_mul_f32 v54, v54, v52
    v_exp_f32 v54, v54
    s_nop 0
    v_add_f32 v54, 1.0, v54
    v_rcp_f32 v54, v54
    s_nop 0
    v_mul_f32 v52, v52, v54
    v_cvt_pk_bf16_f32 v52, v52, v52
    v_cndmask_b32 v53, 0, v52, s[54:55]
    v_cndmask_b32 v54, 0, v52, s[54:55]
    v_cndmask_b32 v52, 0, v52, s[54:55]
    s_nop 1
    v_mov_b32_dpp v53, v52 row_shr:4 row_mask:0xf bank_mask:0xa
    v_mov_b32_dpp v54, v52 row_shl:4 row_mask:0xf bank_mask:0x5
    s_nop 0
    v_and_b32_dpp v156, v53, v4 quad_perm:[0,0,0,0] row_mask:0xf bank_mask:0xf
    v_and_b32_dpp v157, v53, v5 quad_perm:[0,0,0,0] row_mask:0xf bank_mask:0xf
    v_and_b32_dpp v158, v53, v6 quad_perm:[0,0,0,0] row_mask:0xf bank_mask:0xf
    v_and_b32_dpp v159, v53, v7 quad_perm:[0,0,0,0] row_mask:0xf bank_mask:0xf
    v_and_b32_dpp v160, v53, v4 quad_perm:[1,1,1,1] row_mask:0xf bank_mask:0xf
    v_and_b32_dpp v161, v53, v5 quad_perm:[1,1,1,1] row_mask:0xf bank_mask:0xf
    v_and_b32_dpp v162, v53, v6 quad_perm:[1,1,1,1] row_mask:0xf bank_mask:0xf
    v_and_b32_dpp v163, v53, v7 quad_perm:[1,1,1,1] row_mask:0xf bank_mask:0xf
    v_mfma_f32_16x16x32_bf16 v[44:47], v[156:159], v[84:87], 0
    v_and_b32_dpp v164, v53, v4 quad_perm:[2,2,2,2] row_mask:0xf bank_mask:0xf
    v_and_b32_dpp v165, v53, v5 quad_perm:[2,2,2,2] row_mask:0xf bank_mask:0xf
    v_and_b32_dpp v166, v53, v6 quad_perm:[2,2,2,2] row_mask:0xf bank_mask:0xf
    v_and_b32_dpp v167, v53, v7 quad_perm:[2,2,2,2] row_mask:0xf bank_mask:0xf
    v_mfma_f32_16x16x32_bf16 v[44:47], v[160:163], v[88:91], v[44:47]
    v_and_b32_dpp v168, v53, v4 quad_perm:[3,3,3,3] row_mask:0xf bank_mask:0xf
    v_and_b32_dpp v169, v53, v5 quad_perm:[3,3,3,3] row_mask:0xf bank_mask:0xf
    v_and_b32_dpp v170, v53, v6 quad_perm:[3,3,3,3] row_mask:0xf bank_mask:0xf
    v_and_b32_dpp v171, v53, v7 quad_perm:[3,3,3,3] row_mask:0xf bank_mask:0xf
    v_mfma_f32_16x16x32_bf16 v[44:47], v[164:167], v[92:95], v[44:47]
    v_and_b32_dpp v156, v54, v4 quad_perm:[0,0,0,0] row_mask:0xf bank_mask:0xf
    v_and_b32_dpp v157, v54, v5 quad_perm:[0,0,0,0] row_mask:0xf bank_mask:0xf
    v_and_b32_dpp v158, v54, v6 quad_perm:[0,0,0,0] row_mask:0xf bank_mask:0xf
    v_and_b32_dpp v159, v54, v7 quad_perm:[0,0,0,0] row_mask:0xf bank_mask:0xf
    s_waitcnt vmcnt(4)
    v_mfma_f32_16x16x32_bf16 v[44:47], v[168:171], v[96:99], v[44:47]
    v_and_b32_dpp v160, v54, v4 quad_perm:[1,1,1,1] row_mask:0xf bank_mask:0xf
    v_and_b32_dpp v161, v54, v5 quad_perm:[1,1,1,1] row_mask:0xf bank_mask:0xf
    v_and_b32_dpp v162, v54, v6 quad_perm:[1,1,1,1] row_mask:0xf bank_mask:0xf
    v_and_b32_dpp v163, v54, v7 quad_perm:[1,1,1,1] row_mask:0xf bank_mask:0xf
    s_waitcnt vmcnt(3)
    v_mfma_f32_16x16x32_bf16 v[44:47], v[156:159], v[100:103], v[44:47]
    v_and_b32_dpp v164, v54, v4 quad_perm:[2,2,2,2] row_mask:0xf bank_mask:0xf
    v_and_b32_dpp v165, v54, v5 quad_perm:[2,2,2,2] row_mask:0xf bank_mask:0xf
    v_and_b32_dpp v166, v54, v6 quad_perm:[2,2,2,2] row_mask:0xf bank_mask:0xf
    v_and_b32_dpp v167, v54, v7 quad_perm:[2,2,2,2] row_mask:0xf bank_mask:0xf
    s_waitcnt vmcnt(2)
    v_mfma_f32_16x16x32_bf16 v[44:47], v[160:163], v[104:107], v[44:47]
    v_and_b32_dpp v168, v54, v4 quad_perm:[3,3,3,3] row_mask:0xf bank_mask:0xf
    v_and_b32_dpp v169, v54, v5 quad_perm:[3,3,3,3] row_mask:0xf bank_mask:0xf
    v_and_b32_dpp v170, v54, v6 quad_perm:[3,3,3,3] row_mask:0xf bank_mask:0xf
    v_and_b32_dpp v171, v54, v7 quad_perm:[3,3,3,3] row_mask:0xf bank_mask:0xf
    s_waitcnt vmcnt(1)
    v_mfma_f32_16x16x32_bf16 v[44:47], v[164:167], v[108:111], v[44:47]
    s_waitcnt vmcnt(0)
    s_branch L_last1
L_fin:
L_end:
    s_endpgm
L_qslow:
    v_or_b32 v31, v116, v120
    v_and_b32 v31, 0xf0, v31
    v_or3_b32 v31, v30, v123, v31
    v_and_b32 v31, v8, v31
    v_cmp_ne_u32 vcc, 0, v31
    s_cbranch_vccnz L_qretry
    v_mov_b32 v40, 0x200000
    v_and_b32 v116, -16, v116
    v_and_b32 v120, -16, v120
    s_lshl_b32 s35, s30, 13
    s_lshl_b32 s36, s31, 8
    s_add_u32 s35, s35, s36
    s_add_u32 s35, s35, 196608
    v_and_b32 v30, 31, v0
    v_lshlrev_b32 v30, 4, v30
    ds_read_b128 v[140:143], v30 offset:2560
    v_lshl_add_u32 v30, v3, 4, s35
    v_and_b32 v31, 16, v0
    v_lshl_add_u32 v30, v31, 3, v30
    s_mov_b64 exec, 0x00ff00ff
    s_waitcnt lgkmcnt(0)
    global_store_dwordx4 v30, v[140:143], s[28:29] sc1
    s_mov_b64 exec, -1
    ds_write_b32 v23, v40 offset:2048
    s_branch L_qsum
L_qretry:
    s_sub_u32 s37, s37, 1
    s_cbranch_scc1 L_qok
    s_cmp_eq_u32 s37, 199999
    s_cbranch_scc0 L_qre2
    s_waitcnt vmcnt(0)
    v_mov_b32 v116, v124
    v_mov_b32 v117, v125
    v_mov_b32 v118, v126
    v_mov_b32 v119, v127
    v_mov_b32 v120, v128
    v_mov_b32 v121, v129
    v_mov_b32 v122, v130
    v_mov_b32 v123, v131
    s_branch L_qchk
L_qre2:
    s_cmp_gt_u32 s37, 199992
    s_cbranch_scc1 L_qre3
    v_xor_b32 v16, 0x20000, v16
    s_cmp_eq_u32 s37, 199992
    s_cbranch_scc0 L_qre3
    s_lshl_b32 s35, s30, 13
    s_lshl_b32 s36, s31, 8
    s_add_u32 s35, s35, s36
    s_add_u32 s35, s35, 196608
    v_and_b32 v30, 31, v0
    v_lshlrev_b32 v30, 4, v30
    ds_read_b128 v[140:143], v30 offset:2560
    v_lshl_add_u32 v30, v3, 4, s35
    v_and_b32 v31, 16, v0
    v_lshl_add_u32 v30, v31, 3, v30
    s_mov_b64 exec, 0x00ff00ff
    s_waitcnt lgkmcnt(0)
    global_store_dwordx4 v30, v[140:143], s[28:29] sc1
    s_mov_b64 exec, -1
L_qre3:
    global_load_dwordx4 v[116:119], v16, s[28:29] sc1
    global_load_dwordx4 v[120:123], v16, s[28:29] offset:2048 sc1
    s_waitcnt vmcnt(0)
    s_branch L_qchk
L_hretry:
    s_sub_u32 s37, s37, 1
    s_cbranch_scc1 L_hok
    global_load_dwordx4 v[52:55], v20, s[28:29] sc1
    s_waitcnt vmcnt(0)
    s_branch L_hchk
L_oslow:
    global_store_dwordx4 v17, v[116:119], s[28:29] sc1
    s_branch L_opub
L_rslow:
    global_store_dwordx4 v21, v[44:47], s[28:29] sc1
    s_branch L_rpub
.section .rodata,"a"
.p2align 6
.amdhsa_kernel parallel_sum__sliding_block_cached__dense_activation_gelu__decode_kernel
  .amdhsa_next_free_vgpr 192
  .amdhsa_next_free_sgpr 96
  .amdhsa_accum_offset 192
  .amdhsa_group_segment_fixed_size 0
  .amdhsa_kernarg_size 104
  .amdhsa_user_sgpr_count 2
  .amdhsa_user_sgpr_kernarg_segment_ptr 1
  .amdhsa_system_sgpr_workgroup_id_x 1
  .amdhsa_float_denorm_mode_32 3
.end_amdhsa_kernel
```
